```python
import torch

def _softmax(x, axis=-1):
    return torch.softmax(x, dim=axis)
def _gelu(x):
    return torch.nn.functional.gelu(x, approximate="tanh")
def _silu(x):
    return torch.nn.functional.silu(x)
def _sigmoid(x):
    return torch.sigmoid(x)
def _layernorm(x, axis=-1, eps=1e-5):
    m = x.mean(dim=axis, keepdim=True)
    v = x.var(dim=axis, keepdim=True, unbiased=False)
    return (x - m) / torch.sqrt(v + eps)
def _scatter_add(tgt, idx, src, axis=0):
    return tgt.clone().index_add_(axis, idx, src)
def _segment_sum(src, seg, n):
    out = torch.zeros((n,) + src.shape[1:], dtype=src.dtype)
    return out.index_add_(0, seg, src)
def _pad(x, pw):
    flat = tuple(v for pair in reversed(pw) for v in pair)
    return torch.nn.functional.pad(x, flat)

kernel_name = 'gather_scatter__kernel_systems_refs_featgraph__graph'

def setup_inputs():

    _w = (lambda a: (lambda t: t.to(torch.bfloat16) if t.is_floating_point() else t)(torch.as_tensor(a)))
    N, deg, D = 12500, 64, 64
    E = N * deg
    scale = D ** -0.5
    src = (lambda lo, hi, *s: torch.randint(lo, hi, s))(0, N, E).to(torch.int64)
    dst = (lambda lo, hi, *s: torch.randint(lo, hi, s))(0, N, E).to(torch.int64)
    return {
        "x": _w((lambda *s: torch.randn(*s, dtype=torch.bfloat16) * 0.8)(N, D)),
        "src": _w(src),
        "dst": _w(dst),
        "w_q": _w((lambda *s: torch.randn(*s, dtype=torch.bfloat16) * 0.8)(D, D) * scale),
        "w_v": _w((lambda *s: torch.randn(*s, dtype=torch.bfloat16) * 0.05)(D, D) * scale),
    }

def reference(x, src, dst, w_q, w_v):
    N, D = x.shape
    xs = x[src]
    xd = x[dst]
    q = xd @ w_q
    logits = torch.einsum('ed,ed->e', xs, q) * (float(D) ** -0.5)
    alpha = _sigmoid(logits)
    msg = alpha[:, None] * (xs @ w_v)
    return _segment_sum(msg, dst, N)
```

```asm
; @launch grid=(256,1,1) block=(1024,1,1) lds=147968
.amdgcn_target "amdgcn-amd-amdhsa--gfx950"
.text
.globl gather_scatter__kernel_systems_refs_featgraph__graph_kernel
.p2align 8
.type gather_scatter__kernel_systems_refs_featgraph__graph_kernel,@function
gather_scatter__kernel_systems_refs_featgraph__graph_kernel:
    s_cmp_ge_u32 s2, 256
    s_cbranch_scc1 L_end
    s_load_dwordx8 s[16:23], s[0:1], 0
    s_load_dwordx8 s[8:15], s[0:1], 32
    s_getpc_b64 s[92:93]
    v_lshlrev_b32 v88, 7, v0
    v_mov_b32 v89, s93
    v_add_co_u32 v88, vcc, s92, v88
    s_nop 1
    v_addc_co_u32 v89, vcc, 0, v89, vcc
    v_cmp_gt_u32 vcc, 64, v0
    s_and_saveexec_b64 s[92:93], vcc
    s_cbranch_execz L_nocpf
    global_load_dword v123, v[88:89], off offset:128
L_nocpf:
    s_mov_b64 exec, -1
    v_lshrrev_b32 v88, 6, v0
    v_lshlrev_b32 v44, 4, v0
    v_readfirstlane_b32 s36, v88
    s_and_b32 s3, s2, 7
    s_add_u32 s3, s3, 56
    s_lshl_b32 s3, s3, 24
    v_mov_b32 v80, s3
    v_mov_b32 v81, s3
    v_mov_b32 v82, s3
    v_mov_b32 v83, s3
    v_lshrrev_b32 v127, 2, v0
    v_lshl_add_u32 v125, v127, 7, v44
    v_and_b32 v1, 63, v0
    s_mul_i32 s42, s2, 12512
    v_add_u32 v89, s42, v44
    v_mov_b32 v90, 0
    s_mov_b32 s26, 3200000
    s_mov_b32 s27, 0x20000
    s_mov_b32 s70, 16
    s_mov_b32 s71, 0x20000
    s_mov_b32 s98, 256
    s_mov_b32 s99, 0x20000
    s_mov_b32 s58, 0
    s_mov_b32 s59, 0
    v_cmp_gt_u32 vcc, 782, v0
    s_mov_b64 s[62:63], vcc
    v_cmp_gt_u32 vcc, 3200000, v89
    s_and_b64 s[62:63], s[62:63], vcc
    v_lshlrev_b32 v84, 2, v0
    v_cndmask_b32 v89, 4.0, v89, s[62:63]
    s_mov_b32 s49, s2
    s_and_b32 s3, s2, 7
    s_lshl_b32 s3, s3, 5
    s_lshr_b32 s2, s2, 3
    s_or_b32 s2, s2, s3
    s_waitcnt lgkmcnt(0)
    s_mov_b64 s[24:25], s[18:19]
    s_mov_b64 s[96:97], s[12:13]
    s_mov_b64 s[12:13], s[10:11]
    s_mov_b64 s[10:11], s[8:9]
    s_mov_b64 s[8:9], s[22:23]
    s_mov_b32 s22, 3200000
    s_mov_b32 s23, 0x20000
    s_add_u32 s68, s14, 13631488
    s_addc_u32 s69, s15, 0
    buffer_load_dwordx4 v[104:107], v89, s[20:23], 0 offen
    buffer_load_dwordx4 v[108:111], v89, s[24:27], 0 offen
L_twb:
    buffer_load_dwordx4 v[16:19], v90, s[68:71], 0 offen sc1
    ds_write_b128 v125, v[80:83] offset:35072
    ds_write_b128 v125, v[80:83] offset:35136
    ds_write_b128 v125, v[80:83] offset:35200
    s_cmp_lt_u32 s36, 4
    s_cbranch_scc0 L_nopc
    ds_write_b32 v84, v90 offset:17664
L_nopc:
    s_waitcnt lgkmcnt(0)
    s_barrier
    v_lshlrev_b32 v45, 4, v1
    v_and_b32 v88, 16, v1
    v_xor_b32 v88, v88, v45
    s_and_b32 s39, s36, 7
    s_lshl_b32 s39, s39, 10
    s_cmp_lt_u32 s36, 8
    s_cselect_b32 s28, s8, s10
    s_cselect_b32 s29, s9, s11
    s_mov_b32 s30, 8192
    s_mov_b32 s31, 0x20000
    s_cselect_b32 s3, 9216, 0
    s_add_u32 s3, s3, 9472
    s_add_u32 m0, s3, s39
    s_mov_b32 s18, 1600000
    s_mov_b32 s19, 0x20000
    buffer_load_dwordx4 v88, s[28:31], s39 offen lds
    v_bfe_u32 v88, v0, 3, 6
    v_lshlrev_b32 v88, 15, v88
    v_lshrrev_b32 v91, 3, v1
    v_xor_b32 v91, v91, v1
    v_and_b32 v91, 7, v91
    v_lshl_add_u32 v88, v91, 4, v88
    s_lshl_b32 s38, s2, 7
    s_add_u32 m0, s39, 26880
    v_mov_b32 v46, 4
    buffer_load_dwordx4 v88, s[16:19], s38 offen lds
    s_mov_b32 s48, 0x050c0100
    s_mov_b32 s40, 0x30000
    s_add_u32 s3, s36, 15
    s_and_b32 s3, s3, 15
    s_mul_i32 s37, s3, 6144
    s_add_u32 s37, s37, 35072
    s_mul_i32 s3, s49, 16512
    s_add_u32 s28, s14, s3
    s_addc_u32 s29, s15, 0
    s_mov_b32 s30, 8667136
    s_mov_b32 s31, 0x20000
    s_mov_b32 s54, 4325376
    s_mov_b32 s55, 8650752
    s_lshl_b32 s41, s36, 8
    s_add_u32 s41, s41, 135392
    s_mov_b32 s6, 0x00010001
    s_mov_b32 s7, 0x00010001
    v_lshrrev_b32 v89, 4, v1
    v_lshrrev_b32 v88, 3, v1
    v_and_b32 v88, 6, v88
    v_and_b32 v90, 7, v1
    v_xor_b32 v88, v88, v90
    v_lshlrev_b32 v2, 4, v88
    v_xor_b32 v3, 16, v2
    v_and_b32 v88, 6, v1
    v_bfe_u32 v90, v1, 3, 1
    v_or_b32 v88, v88, v90
    v_lshlrev_b32 v90, 1, v89
    v_xor_b32 v88, v88, v90
    v_lshlrev_b32 v88, 4, v88
    v_and_b32 v90, 15, v1
    v_lshl_add_u32 v88, v90, 7, v88
    v_add_u32 v5, s37, v88
    v_xor_b32 v6, 16, v5
    v_cmp_eq_u32 s[64:65], 0, v90
    s_nop 1
    v_cndmask_b32 v11, 0, -1, s[64:65]
    v_cmp_eq_u32 s[64:65], 1, v90
    s_nop 1
    v_cndmask_b32 v12, 0, -1, s[64:65]
    v_cmp_eq_u32 s[64:65], 2, v90
    s_nop 1
    v_cndmask_b32 v13, 0, -1, s[64:65]
    v_cmp_eq_u32 s[64:65], 3, v90
    s_nop 1
    v_cndmask_b32 v14, 0, -1, s[64:65]
    v_lshlrev_b32 v88, 4, v90
    v_add_u32 v88, s36, v88
    s_movk_i32 s3, 144
    v_mul_u32_u24 v88, s3, v88
    v_lshl_add_u32 v24, v89, 5, v88
    s_lshr_b32 s3, s36, 2
    s_lshl_b32 s3, s3, 4
    v_add_u32 v90, s3, v90
    v_and_b32 v88, 7, v1
    v_xor_b32 v88, v88, v89
    v_lshlrev_b32 v88, 4, v88
    v_lshl_add_u32 v21, v90, 7, v88
    v_xor_b32 v22, 64, v21
    s_movk_i32 s3, 144
    v_mul_u32_u24 v90, s3, v90
    v_lshl_add_u32 v90, v89, 3, v90
    s_and_b32 s3, s36, 3
    s_lshl_b32 s3, s3, 5
    v_add_u32 v23, s3, v90
    v_lshlrev_b32 v88, 10, v89
    v_bfe_u32 v90, v1, 2, 2
    v_lshl_add_u32 v88, v90, 7, v88
    v_and_b32 v90, 3, v1
    v_lshl_add_u32 v88, v90, 3, v88
    v_add_u32 v88, s3, v88
    v_lshlrev_b32 v122, 4, v90
    v_lshlrev_b32 v90, 1, v1
    v_and_b32 v90, 16, v90
    v_xor_b32 v20, v88, v90
    v_lshrrev_b32 v88, 2, v1
    v_and_b32 v90, 6, v88
    v_lshrrev_b32 v91, 3, v88
    v_or_b32 v90, v90, v91
    v_bfe_u32 v91, v1, 1, 1
    v_xor_b32 v90, v90, v91
    v_lshlrev_b32 v90, 4, v90
    v_lshl_add_u32 v90, v88, 7, v90
    v_and_b32 v91, 1, v1
    v_lshl_add_u32 v90, v91, 3, v90
    v_add_u32 v7, s37, v90
    v_xor_b32 v8, 32, v7
    v_xor_b32 v9, 64, v7
    v_xor_b32 v10, 96, v7
    v_mov_b32 v15, 0xbe38aa3b
    s_movk_i32 s3, 16512
    v_mad_u32_u24 v120, v127, s3, v122
    s_lshl_b32 s3, s2, 6
    v_add_u32 v120, s3, v120
    v_add_u32 v121, 4325376, v120
    v_lshlrev_b32 v127, 2, v127
    v_add_u32 v122, 64, v122
    s_mov_b32 s68, s14
    s_mov_b32 s69, s15
    s_mov_b32 s70, 12877824
    s_mov_b32 s71, 0x20000
    v_mov_b32 v124, 2
    s_mov_b64 s[60:61], -1
    s_mov_b64 s[56:57], 0
    s_movk_i32 s66, 4096
    s_mov_b32 s67, 0
    s_mov_b32 s46, 0xc0ffc000
    s_mov_b32 s47, 0xc003c000
    s_movk_i32 s44, 188
    s_movk_i32 s45, 252
    s_mov_b64 exec, s[62:63]
    s_waitcnt vmcnt(4)
    v_lshlrev_b32_sdwa v112, 2, v104 dst_sel:DWORD dst_unused:UNUSED_PAD src0_sel:DWORD src1_sel:BYTE_0
    v_lshlrev_b32_sdwa v113, 2, v105 dst_sel:DWORD dst_unused:UNUSED_PAD src0_sel:DWORD src1_sel:BYTE_0
    v_lshlrev_b32_sdwa v114, 2, v106 dst_sel:DWORD dst_unused:UNUSED_PAD src0_sel:DWORD src1_sel:BYTE_0
    v_lshlrev_b32_sdwa v115, 2, v107 dst_sel:DWORD dst_unused:UNUSED_PAD src0_sel:DWORD src1_sel:BYTE_0
    ds_add_rtn_u32 v116, v112, v46 offset:17664
    ds_add_rtn_u32 v117, v113, v46 offset:17664
    ds_add_rtn_u32 v118, v114, v46 offset:17664
    ds_add_rtn_u32 v119, v115, v46 offset:17664
    s_waitcnt vmcnt(3)
    v_perm_b32 v108, v104, v108, s48
    v_perm_b32 v109, v105, v109, s48
    v_perm_b32 v110, v106, v110, s48
    v_perm_b32 v111, v107, v111, s48
    s_waitcnt lgkmcnt(3)
    v_min_u32 v116, s44, v116
    v_mad_u32_u24 v116, v112, 48, v116
    ds_write_b32 v116, v108 offset:35072
    s_waitcnt lgkmcnt(3)
    v_min_u32 v117, s44, v117
    v_mad_u32_u24 v117, v113, 48, v117
    ds_write_b32 v117, v109 offset:35072
    s_waitcnt lgkmcnt(3)
    v_min_u32 v118, s44, v118
    v_mad_u32_u24 v118, v114, 48, v118
    ds_write_b32 v118, v110 offset:35072
    s_waitcnt lgkmcnt(3)
    v_min_u32 v119, s44, v119
    v_mad_u32_u24 v119, v115, 48, v119
    ds_write_b32 v119, v111 offset:35072
    s_mov_b64 exec, -1
    s_waitcnt vmcnt(2)
    v_readfirstlane_b32 s50, v16
    v_readfirstlane_b32 s51, v17
    v_readfirstlane_b32 s52, v18
    v_readfirstlane_b32 s53, v19
    s_bfe_u32 s42, s51, 0xa000e
    s_bfe_u32 s43, s52, 0xa000e
    s_bfe_u32 s3, s53, 0xa000e
    s_lshl_b32 s43, s43, 10
    s_lshl_b32 s3, s3, 20
    s_or_b32 s42, s42, s43
    s_or_b32 s42, s42, s3
    s_add_u32 s42, s42, 1
    s_and_b32 s50, s50, 0xc003c000
    s_and_b32 s51, s51, 0xc0000000
    s_bfe_u32 s43, s42, 0xa0000
    s_lshl_b32 s43, s43, 14
    s_or_b32 s51, s51, s43
    s_and_b32 s52, s52, 0xc0000000
    s_bfe_u32 s43, s42, 0xa000a
    s_lshl_b32 s43, s43, 14
    s_or_b32 s52, s52, s43
    s_and_b32 s53, s53, 0xc0000000
    s_bfe_u32 s43, s42, 0xa0014
    s_lshl_b32 s43, s43, 14
    s_or_b32 s53, s53, s43
    s_waitcnt lgkmcnt(0)
    s_barrier
    ds_read_b32 v112, v127 offset:17664
    ds_read_b128 v[104:107], v125 offset:35072
    ds_read_b128 v[108:111], v125 offset:35136
    s_waitcnt lgkmcnt(2)
    v_cmp_lt_u32 s[64:65], v122, v112
    v_cmp_lt_u32 vcc, 128, v112
    v_min_u32 v113, s45, v112
    v_lshl_or_b32 v113, v113, 16, s50
    s_waitcnt lgkmcnt(1)
    v_xor_b32 v104, v113, v104
    v_xor_b32 v105, s51, v105
    v_xor_b32 v106, s52, v106
    v_xor_b32 v107, s53, v107
    buffer_store_dwordx4 v[104:107], v44, s[28:31], 0 offen sc1
    v_cndmask_b32 v114, 4.0, v44, s[64:65]
    s_waitcnt lgkmcnt(0)
    v_xor_b32 v108, v113, v108
    v_xor_b32 v109, s51, v109
    v_xor_b32 v110, s52, v110
    v_xor_b32 v111, s53, v111
    buffer_store_dwordx4 v[108:111], v114, s[28:31], s54 offen sc1
    s_cbranch_vccnz L_third
L_third_done:
    s_mov_b32 s32, s12
    s_mov_b32 s33, s13
    s_mov_b32 s34, 1600000
    s_mov_b32 s35, 0x20000
    v_mov_b32 v96, -1
    v_mov_b32 v97, -1
    v_mov_b32 v98, -1
    v_mov_b32 v99, -1
    v_lshlrev_b32 v100, 4, v0
    v_add_u32 v100, 135424, v100
    v_cmp_gt_u32 vcc, 784, v0
    s_mov_b64 exec, vcc
    ds_write_b128 v100, v[96:99]
    s_mov_b64 exec, -1
    s_cmp_lg_u32 s36, 13
    s_cbranch_scc1 I1
    v_lshlrev_b32 v101, 2, v1
    v_lshlrev_b32 v102, 8, v1
    v_add_u32 v102, 135424, v102
    v_mov_b32 v100, s40
    v_cmp_le_u32 vcc, 56, v1
    s_nop 1
    v_cndmask_b32 v102, v102, v100, vcc
    ds_write_b32 v101, v102 offset:0
I1:
    v_mov_b32 v28, 0
    v_mov_b32 v29, 0
    v_mov_b32 v30, 0
    v_mov_b32 v31, 0
    v_mov_b32 v32, 0
    v_mov_b32 v33, 0
    v_mov_b32 v34, 0
    v_mov_b32 v35, 0
    v_mov_b32 v36, 0
    v_mov_b32 v37, 0
    v_mov_b32 v38, 0
    v_mov_b32 v39, 0
    v_mov_b32 v40, 0
    v_mov_b32 v41, 0
    v_mov_b32 v42, 0
    v_mov_b32 v43, 0
    s_cmp_lg_u32 s59, 0
    s_cbranch_scc1 WB3
    s_waitcnt vmcnt(2)
WB3:
    s_waitcnt vmcnt(3)
    s_barrier
    ds_read_b64_tr_b16 v[88:89], v20 offset:18688
    ds_read_b64_tr_b16 v[90:91], v20 offset:19200
    ds_read_b64_tr_b16 v[92:93], v20 offset:22784
    ds_read_b64_tr_b16 v[94:95], v20 offset:23296
    ds_read_b128 v[80:83], v21 offset:26880
    ds_read_b128 v[84:87], v22 offset:26880
    s_waitcnt lgkmcnt(0)
    v_mfma_f32_16x16x32_bf16 v[44:47], v[88:91], v[80:83], 0
    v_mfma_f32_16x16x32_bf16 v[44:47], v[92:95], v[84:87], v[44:47]
    v_mov_b32 v48, 0
    v_mov_b32 v49, 0
    v_mov_b32 v50, 0
    v_mov_b32 v51, 0
    v_mov_b32 v52, 0
    v_mov_b32 v53, 0
    v_mov_b32 v54, 0
    v_mov_b32 v55, 0
    v_mov_b32 v56, 0
    v_mov_b32 v57, 0
    v_mov_b32 v58, 0
    v_mov_b32 v59, 0
    v_mov_b32 v60, 0
    v_mov_b32 v61, 0
    v_mov_b32 v62, 0
    v_mov_b32 v63, 0
    v_mov_b32 v64, 0
    v_mov_b32 v65, 0
    v_mov_b32 v66, 0
    v_mov_b32 v67, 0
    v_mov_b32 v68, 0
    v_mov_b32 v69, 0
    v_mov_b32 v70, 0
    v_mov_b32 v71, 0
    v_mov_b32 v72, 0
    v_mov_b32 v73, 0
    v_mov_b32 v74, 0
    v_mov_b32 v75, 0
    v_mov_b32 v76, 0
    v_mov_b32 v77, 0
    v_mov_b32 v78, 0
    v_mov_b32 v79, 0
    v_cvt_pk_bf16_f32 v80, v44, v45
    v_cvt_pk_bf16_f32 v81, v46, v47
    ds_write_b64 v23, v[80:81] offset:256
    s_waitcnt lgkmcnt(0)
    s_barrier
    buffer_load_dwordx4 v[104:107], v120, s[68:71], 0 offen sc1
    s_lshl_b64 exec, s[6:7], 0
    ds_read_b128 v[48:51], v24 offset:256
    ds_read_b128 v[52:55], v24 offset:272
    s_lshl_b64 exec, s[6:7], 1
    ds_read_b128 v[56:59], v24 offset:256
    ds_read_b128 v[60:63], v24 offset:272
    s_lshl_b64 exec, s[6:7], 2
    ds_read_b128 v[64:67], v24 offset:256
    ds_read_b128 v[68:71], v24 offset:272
    s_lshl_b64 exec, s[6:7], 3
    ds_read_b128 v[72:75], v24 offset:256
    ds_read_b128 v[76:79], v24 offset:272
    s_mov_b64 exec, -1
    v_lshrrev_b32 v25, 3, v1
    v_lshl_add_u32 v25, v25, 1, s41
    v_lshlrev_b32 v44, 2, v1
    v_lshlrev_b32 v45, 8, v1
    v_subrev_u32 v45, 4294831903, v45
    v_add_u32 v4, 160, v25
    s_add_u32 s84, s36, 16
    s_add_u32 s85, s36, 32
    s_add_u32 s86, s36, 48
    s_min_u32 s86, s86, 49
    s_movk_i32 s87, 287
    s_setprio 3
    s_waitcnt vmcnt(0)
L_hv:
    v_xor_b32 v104, s50, v104
    v_xor_b32 v105, s51, v105
    v_xor_b32 v106, s52, v106
    v_xor_b32 v107, s53, v107
    v_or3_b32 v113, v105, v106, v107
    v_and_b32 v113, s46, v113
    v_and_or_b32 v113, v104, s47, v113
    v_cmp_ne_u32 s[60:61], 0, v113
    s_cmp_lg_u64 s[60:61], 0
    s_cbranch_scc1 L_hretry
L_hok:
    s_mov_b64 exec, -1
    v_bfe_u32 v112, v104, 16, 8
    v_cmp_lt_u32 vcc, s44, v112
    v_cmp_lt_u32 s[62:63], v122, v112
    s_or_b64 s[56:57], s[56:57], vcc
    s_andn2_b64 s[62:63], s[62:63], s[56:57]
    s_mov_b64 s[74:75], s[62:63]
    v_cndmask_b32 v114, 4.0, v121, s[62:63]
    buffer_load_dwordx4 v[108:111], v114, s[68:71], 0 offen sc1
    s_setprio 0
    v_and_b32 v104, 0x3f003fff, v104
    v_add_u32 v115, 64, v112
    v_sub_u32 v115, v115, v122
    s_andn2_b64 exec, -1, s[56:57]
    v_cmp_lt_i32 s[42:43], 0, v115
    v_cmp_lt_i32 s[64:65], 4, v115
    v_cmp_lt_i32 s[72:73], 8, v115
    v_cmp_lt_i32 s[76:77], 12, v115
    s_mov_b64 exec, s[42:43]
    v_lshrrev_b32 v80, 22, v104
    ds_add_rtn_u32 v80, v80, v124 offset:0
    s_mov_b64 exec, s[64:65]
    v_lshrrev_b32 v81, 22, v105
    ds_add_rtn_u32 v81, v81, v124 offset:0
    s_mov_b64 exec, s[72:73]
    v_lshrrev_b32 v82, 22, v106
    ds_add_rtn_u32 v82, v82, v124 offset:0
    s_mov_b64 exec, s[76:77]
    v_lshrrev_b32 v83, 22, v107
    ds_add_rtn_u32 v83, v83, v124 offset:0
    s_mov_b64 exec, s[42:43]
    s_waitcnt lgkmcnt(3)
    ds_write_b16 v80, v104
    s_mov_b64 exec, s[64:65]
    s_waitcnt lgkmcnt(3)
    ds_write_b16 v81, v105
    s_mov_b64 exec, s[72:73]
    s_waitcnt lgkmcnt(3)
    ds_write_b16 v82, v106
    s_mov_b64 exec, s[76:77]
    s_waitcnt lgkmcnt(3)
    ds_write_b16 v83, v107
    s_mov_b32 s13, 0
L_sec:
    s_mov_b64 exec, s[62:63]
    s_cbranch_execz L_secdone
    s_waitcnt vmcnt(0)
L_sv:
    v_xor_b32 v108, s50, v108
    v_xor_b32 v109, s51, v109
    v_xor_b32 v110, s52, v110
    v_xor_b32 v111, s53, v111
    v_or3_b32 v113, v109, v110, v111
    v_and_b32 v113, s46, v113
    v_and_or_b32 v113, v108, s47, v113
    v_cmp_ne_u32 s[62:63], 0, v113
    s_cmp_lg_u64 s[62:63], 0
    s_cbranch_scc1 L_sretry
    s_mov_b64 exec, s[74:75]
    v_and_b32 v108, 0x3f003fff, v108
    v_lshrrev_b32 v84, 22, v108
    ds_add_rtn_u32 v84, v84, v124 offset:0
    v_lshrrev_b32 v85, 22, v109
    ds_add_rtn_u32 v85, v85, v124 offset:0
    v_lshrrev_b32 v86, 22, v110
    ds_add_rtn_u32 v86, v86, v124 offset:0
    v_lshrrev_b32 v87, 22, v111
    ds_add_rtn_u32 v87, v87, v124 offset:0
    s_waitcnt lgkmcnt(3)
    ds_write_b16 v84, v108
    s_waitcnt lgkmcnt(3)
    ds_write_b16 v85, v109
    s_waitcnt lgkmcnt(3)
    ds_write_b16 v86, v110
    s_waitcnt lgkmcnt(3)
    ds_write_b16 v87, v111
    s_mov_b64 exec, -1
    v_add_u32 v122, 64, v122
    v_add_u32 v121, 4325376, v121
    v_cmp_lt_u32 s[62:63], v122, v112
    s_and_b64 s[62:63], s[62:63], s[74:75]
    s_cbranch_scc1 L_more
L_secdone:
    s_mov_b64 exec, -1
    s_cmp_lg_u64 s[56:57], 0
    s_cbranch_scc1 L_rescan
L_b6:
    s_waitcnt lgkmcnt(0)
    s_barrier
L_counts:
    ds_read_b32 v26, v44 offset:0
    ds_read_u16 v16, v4 offset:0
    ds_read_u16 v17, v4 offset:16
    ds_read_u16 v18, v4 offset:4096
    ds_read_u16 v19, v4 offset:4112
    ds_read_u16 v20, v4 offset:8192
    ds_read_u16 v21, v4 offset:8208
    ds_read_u16 v22, v4 offset:12288
    ds_read_u16 v23, v4 offset:12304
    s_waitcnt lgkmcnt(8)
    v_sub_u32 v26, v26, v45
    v_cmp_lt_u32 vcc, s87, v26
    v_lshrrev_b32 v26, 5, v26
    s_and_b32 vcc_hi, vcc_hi, 0xffffff
    v_readlane_b32 s59, v26, 53
    s_or_b32 s58, s58, s59
    s_cmp_lg_u64 vcc, 0
    s_cbranch_scc1 L_slow
    v_readlane_b32 s45, v26, s36
    v_readlane_b32 s46, v26, s84
    v_readlane_b32 s47, v26, s85
    v_readlane_b32 s48, v26, s86
    s_max_u32 s42, s45, s46
    s_max_u32 s42, s42, s47
    s_max_u32 s42, s42, s48
    s_cmp_lg_u32 s42, 0
    s_cbranch_scc0 L_r0
    s_lshl_b32 s3, s42, 5
    s_cmp_lg_u32 s48, 0
    s_cbranch_scc1 L_m4
    s_cmp_eq_u32 s42, 5
    s_cbranch_scc1 M3_spec
    v_add_u32 v4, s3, v25
    ds_read_u16 v16, v4 offset:0
    ds_read_u16 v17, v4 offset:16
    ds_read_u16 v18, v4 offset:4096
    ds_read_u16 v19, v4 offset:4112
    ds_read_u16 v20, v4 offset:8192
    ds_read_u16 v21, v4 offset:8208
M3_spec:
    s_min_u32 s44, s45, s46
    s_min_u32 s44, s44, s47
    s_sub_u32 s43, s42, 1
    s_waitcnt lgkmcnt(0)
    s_cmp_lt_u32 s43, s45
    s_cbranch_scc0 D2_0
    v_lshl_add_u32 v16, v16, 7, v2
    s_add_u32 m0, s37, 0
    v_lshl_add_u32 v17, v17, 7, v3
    buffer_load_dwordx4 v16, s[16:19], 0 offen lds
    s_add_u32 m0, s37, 1024
    s_nop 0
    buffer_load_dwordx4 v17, s[16:19], 0 offen lds
D2_0:
    s_cmp_lt_u32 s43, s46
    s_cbranch_scc0 D2_1
    v_lshl_add_u32 v18, v18, 7, v2
    s_add_u32 m0, s37, 2048
    v_lshl_add_u32 v19, v19, 7, v3
    buffer_load_dwordx4 v18, s[16:19], 0 offen lds
    s_add_u32 m0, s37, 3072
    s_nop 0
    buffer_load_dwordx4 v19, s[16:19], 0 offen lds
D2_1:
    s_cmp_lt_u32 s43, s47
    s_cbranch_scc0 D2_2
    v_lshl_add_u32 v20, v20, 7, v2
    s_add_u32 m0, s37, 4096
    v_lshl_add_u32 v21, v21, 7, v3
    buffer_load_dwordx4 v20, s[16:19], 0 offen lds
    s_add_u32 m0, s37, 5120
    s_nop 0
    buffer_load_dwordx4 v21, s[16:19], 0 offen lds
D2_2:
    v_mov_b32 v104, 0
    v_mov_b32 v105, 0
    v_mov_b32 v106, 0
    v_mov_b32 v107, 0
    v_mov_b32 v108, 0
    v_mov_b32 v109, 0
    v_mov_b32 v110, 0
    v_mov_b32 v111, 0
    v_mov_b32 v112, 0
    v_mov_b32 v113, 0
    v_mov_b32 v114, 0
    v_mov_b32 v115, 0
    v_mov_b32 v116, 0
    v_mov_b32 v117, 0
    v_mov_b32 v118, 0
    v_mov_b32 v119, 0
M3_loop:
    s_setprio 3
    s_cmp_gt_u32 s42, 3
    s_cbranch_scc1 M3_pd
    s_setprio 2
    s_cmp_gt_u32 s42, 2
    s_cbranch_scc1 M3_pd
    s_setprio 1
    s_cmp_gt_u32 s42, 1
    s_cbranch_scc1 M3_pd
    s_setprio 0
M3_pd:
    v_subrev_u32 v4, 32, v4
    s_sub_u32 s42, s42, 1
    s_sub_u32 s43, s42, 1
    ds_read_u16 v16, v4 offset:0
    ds_read_u16 v17, v4 offset:16
    ds_read_u16 v18, v4 offset:4096
    ds_read_u16 v19, v4 offset:4112
    ds_read_u16 v20, v4 offset:8192
    ds_read_u16 v21, v4 offset:8208
    s_cmp_ge_u32 s42, s44
    s_cbranch_scc1 M3_ramp
    s_waitcnt vmcnt(0)
    ds_read_b128 v[80:83], v5 offset:0
    ds_read_b128 v[84:87], v6 offset:0
    ds_read_b128 v[88:91], v5 offset:2048
    ds_read_b128 v[92:95], v6 offset:2048
    ds_read_b128 v[96:99], v5 offset:4096
    ds_read_b128 v[100:103], v6 offset:4096
    ds_read_b64_tr_b16 v[104:105], v7 offset:0
    ds_read_b64_tr_b16 v[108:109], v8 offset:0
    ds_read_b64_tr_b16 v[112:113], v9 offset:0
    ds_read_b64_tr_b16 v[116:117], v10 offset:0
    ds_read_b64_tr_b16 v[106:107], v7 offset:2048
    ds_read_b64_tr_b16 v[110:111], v8 offset:2048
    s_waitcnt lgkmcnt(10)
    v_mfma_f32_16x16x32_bf16 v[44:47], v[80:83], v[48:51], 0
    v_mfma_f32_16x16x32_bf16 v[44:47], v[84:87], v[52:55], v[44:47]
    ds_read_b64_tr_b16 v[114:115], v9 offset:2048
    ds_read_b64_tr_b16 v[118:119], v10 offset:2048
    ds_read_b64_tr_b16 v[120:121], v7 offset:4096
    ds_read_b64_tr_b16 v[122:123], v8 offset:4096
    ds_read_b64_tr_b16 v[124:125], v9 offset:4096
    ds_read_b64_tr_b16 v[126:127], v10 offset:4096
    s_waitcnt lgkmcnt(12)
    v_mfma_f32_16x16x32_bf16 v[44:47], v[88:91], v[56:59], v[44:47]
    v_mfma_f32_16x16x32_bf16 v[44:47], v[92:95], v[60:63], v[44:47]
    v_mfma_f32_16x16x32_bf16 v[44:47], v[96:99], v[64:67], v[44:47]
    v_mfma_f32_16x16x32_bf16 v[44:47], v[100:103], v[68:71], v[44:47]
    s_waitcnt lgkmcnt(0)
    s_cmp_eq_u32 s42, 0
    s_cbranch_scc1 M3_last
    v_lshl_add_u32 v16, v16, 7, v2
    s_add_u32 m0, s37, 0
    v_lshl_add_u32 v17, v17, 7, v3
    buffer_load_dwordx4 v16, s[16:19], 0 offen lds
    s_add_u32 m0, s37, 1024
    s_nop 0
    buffer_load_dwordx4 v17, s[16:19], 0 offen lds
    v_lshl_add_u32 v18, v18, 7, v2
    s_add_u32 m0, s37, 2048
    v_lshl_add_u32 v19, v19, 7, v3
    buffer_load_dwordx4 v18, s[16:19], 0 offen lds
    s_add_u32 m0, s37, 3072
    s_nop 0
    buffer_load_dwordx4 v19, s[16:19], 0 offen lds
    v_lshl_add_u32 v20, v20, 7, v2
    s_add_u32 m0, s37, 4096
    v_lshl_add_u32 v21, v21, 7, v3
    buffer_load_dwordx4 v20, s[16:19], 0 offen lds
    s_add_u32 m0, s37, 5120
    s_nop 0
    buffer_load_dwordx4 v21, s[16:19], 0 offen lds
M3_nodma:
    v_mul_f32 v25, v44, v15
    v_mul_f32_dpp v25, v45, v15 row_shr:4 row_mask:0xf bank_mask:0x2
    v_mul_f32_dpp v25, v46, v15 row_shr:8 row_mask:0xf bank_mask:0x4
    v_mul_f32_dpp v25, v47, v15 row_shr:12 row_mask:0xf bank_mask:0x8
    v_exp_f32 v25, v25
    s_nop 0
    v_add_f32 v25, 1.0, v25
    v_rcp_f32 v25, v25
    s_nop 1
    v_mov_b32_dpp v26, v25 row_shl:4 row_mask:0xf bank_mask:0xf bound_ctrl:0
    v_cvt_pk_bf16_f32 v26, v25, v26
    v_and_b32 v88, v26, v11
    v_and_b32 v90, v26, v12
    v_and_b32 v92, v26, v13
    v_and_b32_dpp v89, v26, v11 row_shl:8 row_mask:0xf bank_mask:0xf bound_ctrl:0
    v_and_b32_dpp v91, v26, v12 row_shl:8 row_mask:0xf bank_mask:0xf bound_ctrl:0
    v_and_b32_dpp v93, v26, v13 row_shl:8 row_mask:0xf bank_mask:0xf bound_ctrl:0
    s_nop 1
    v_mfma_f32_16x16x32_bf16 v[28:31], v[104:107], v[88:91], v[28:31]
    v_mfma_f32_16x16x32_bf16 v[32:35], v[108:111], v[88:91], v[32:35]
    v_mfma_f32_16x16x32_bf16 v[36:39], v[112:115], v[88:91], v[36:39]
    v_mfma_f32_16x16x32_bf16 v[40:43], v[116:119], v[88:91], v[40:43]
    v_mfma_f32_16x16x16_bf16 v[28:31], v[120:121], v[92:93], v[28:31]
    v_mfma_f32_16x16x16_bf16 v[32:35], v[122:123], v[92:93], v[32:35]
    v_mfma_f32_16x16x16_bf16 v[36:39], v[124:125], v[92:93], v[36:39]
    v_mfma_f32_16x16x16_bf16 v[40:43], v[126:127], v[92:93], v[40:43]
    s_cmp_lg_u32 s42, 0
    s_cbranch_scc1 M3_loop
    s_branch L_loop_done
M3_last:
    s_nop 4
    s_cmp_lg_u32 s67, 0
    s_cbranch_scc1 M3_nodma
    v_lshrrev_b32 v16, 2, v1
    v_lshlrev_b32 v16, 7, v16
    v_and_b32 v17, 3, v1
    v_lshl_add_u32 v16, v17, 5, v16
    v_lshlrev_b32 v17, 1, v1
    v_and_b32 v17, 16, v17
    v_or_b32 v16, v16, v17
    v_xor_b32 v17, 16, v16
    ds_read_b64_tr_b16 v[48:49], v16 offset:9472
    ds_read_b64_tr_b16 v[50:51], v16 offset:11520
    ds_read_b64_tr_b16 v[52:53], v16 offset:13568
    ds_read_b64_tr_b16 v[54:55], v16 offset:15616
    ds_read_b64_tr_b16 v[56:57], v16 offset:9480
    ds_read_b64_tr_b16 v[58:59], v16 offset:11528
    ds_read_b64_tr_b16 v[60:61], v16 offset:13576
    ds_read_b64_tr_b16 v[62:63], v16 offset:15624
    ds_read_b64_tr_b16 v[64:65], v17 offset:9472
    ds_read_b64_tr_b16 v[66:67], v17 offset:11520
    ds_read_b64_tr_b16 v[68:69], v17 offset:13568
    ds_read_b64_tr_b16 v[70:71], v17 offset:15616
    ds_read_b64_tr_b16 v[72:73], v17 offset:9480
    ds_read_b64_tr_b16 v[74:75], v17 offset:11528
    ds_read_b64_tr_b16 v[76:77], v17 offset:13576
    ds_read_b64_tr_b16 v[78:79], v17 offset:15624
    s_branch M3_nodma
M3_ramp:
    v_mov_b32 v44, 0
    v_mov_b32 v45, 0
    v_mov_b32 v46, 0
    v_mov_b32 v47, 0
    s_waitcnt vmcnt(0)
    s_cmp_lt_u32 s42, s45
    s_cbranch_scc0 M3_r10
    ds_read_b128 v[80:83], v5 offset:0
    ds_read_b128 v[84:87], v6 offset:0
    ds_read_b64_tr_b16 v[104:105], v7 offset:0
    ds_read_b64_tr_b16 v[108:109], v8 offset:0
    ds_read_b64_tr_b16 v[112:113], v9 offset:0
    ds_read_b64_tr_b16 v[116:117], v10 offset:0
M3_r10:
    s_cmp_lt_u32 s42, s46
    s_cbranch_scc0 M3_r11
    ds_read_b128 v[88:91], v5 offset:2048
    ds_read_b128 v[92:95], v6 offset:2048
    ds_read_b64_tr_b16 v[106:107], v7 offset:2048
    ds_read_b64_tr_b16 v[110:111], v8 offset:2048
    ds_read_b64_tr_b16 v[114:115], v9 offset:2048
    ds_read_b64_tr_b16 v[118:119], v10 offset:2048
M3_r11:
    s_cmp_lt_u32 s42, s47
    s_cbranch_scc0 M3_r12
    ds_read_b128 v[96:99], v5 offset:4096
    ds_read_b128 v[100:103], v6 offset:4096
    ds_read_b64_tr_b16 v[120:121], v7 offset:4096
    ds_read_b64_tr_b16 v[122:123], v8 offset:4096
    ds_read_b64_tr_b16 v[124:125], v9 offset:4096
    ds_read_b64_tr_b16 v[126:127], v10 offset:4096
M3_r12:
    s_waitcnt lgkmcnt(0)
    s_cmp_lt_u32 s42, s45
    s_cbranch_scc0 M3_r20
    v_mfma_f32_16x16x32_bf16 v[44:47], v[80:83], v[48:51], v[44:47]
    v_mfma_f32_16x16x32_bf16 v[44:47], v[84:87], v[52:55], v[44:47]
M3_r20:
    s_cmp_lt_u32 s42, s46
    s_cbranch_scc0 M3_r21
    v_mfma_f32_16x16x32_bf16 v[44:47], v[88:91], v[56:59], v[44:47]
    v_mfma_f32_16x16x32_bf16 v[44:47], v[92:95], v[60:63], v[44:47]
M3_r21:
    s_cmp_lt_u32 s42, s47
    s_cbranch_scc0 M3_r22
    v_mfma_f32_16x16x32_bf16 v[44:47], v[96:99], v[64:67], v[44:47]
    v_mfma_f32_16x16x32_bf16 v[44:47], v[100:103], v[68:71], v[44:47]
M3_r22:
    s_cmp_eq_u32 s42, 0
    s_cbranch_scc1 M3_rlast
    s_cmp_lt_u32 s43, s45
    s_cbranch_scc0 D4_0
    v_lshl_add_u32 v16, v16, 7, v2
    s_add_u32 m0, s37, 0
    v_lshl_add_u32 v17, v17, 7, v3
    buffer_load_dwordx4 v16, s[16:19], 0 offen lds
    s_add_u32 m0, s37, 1024
    s_nop 0
    buffer_load_dwordx4 v17, s[16:19], 0 offen lds
D4_0:
    s_cmp_lt_u32 s43, s46
    s_cbranch_scc0 D4_1
    v_lshl_add_u32 v18, v18, 7, v2
    s_add_u32 m0, s37, 2048
    v_lshl_add_u32 v19, v19, 7, v3
    buffer_load_dwordx4 v18, s[16:19], 0 offen lds
    s_add_u32 m0, s37, 3072
    s_nop 0
    buffer_load_dwordx4 v19, s[16:19], 0 offen lds
D4_1:
    s_cmp_lt_u32 s43, s47
    s_cbranch_scc0 D4_2
    v_lshl_add_u32 v20, v20, 7, v2
    s_add_u32 m0, s37, 4096
    v_lshl_add_u32 v21, v21, 7, v3
    buffer_load_dwordx4 v20, s[16:19], 0 offen lds
    s_add_u32 m0, s37, 5120
    s_nop 0
    buffer_load_dwordx4 v21, s[16:19], 0 offen lds
D4_2:
M3_rnodma:
    s_nop 7
    v_mul_f32 v25, v44, v15
    v_mul_f32_dpp v25, v45, v15 row_shr:4 row_mask:0xf bank_mask:0x2
    v_mul_f32_dpp v25, v46, v15 row_shr:8 row_mask:0xf bank_mask:0x4
    v_mul_f32_dpp v25, v47, v15 row_shr:12 row_mask:0xf bank_mask:0x8
    v_exp_f32 v25, v25
    s_nop 0
    v_add_f32 v25, 1.0, v25
    v_rcp_f32 v25, v25
    s_nop 1
    v_mov_b32_dpp v26, v25 row_shl:4 row_mask:0xf bank_mask:0xf bound_ctrl:0
    v_cvt_pk_bf16_f32 v26, v25, v26
    v_and_b32 v88, v26, v11
    v_and_b32 v90, v26, v12
    v_and_b32 v92, v26, v13
    v_and_b32_dpp v89, v26, v11 row_shl:8 row_mask:0xf bank_mask:0xf bound_ctrl:0
    v_and_b32_dpp v91, v26, v12 row_shl:8 row_mask:0xf bank_mask:0xf bound_ctrl:0
    v_and_b32_dpp v93, v26, v13 row_shl:8 row_mask:0xf bank_mask:0xf bound_ctrl:0
    s_nop 1
    v_mfma_f32_16x16x32_bf16 v[28:31], v[104:107], v[88:91], v[28:31]
    v_mfma_f32_16x16x32_bf16 v[32:35], v[108:111], v[88:91], v[32:35]
    v_mfma_f32_16x16x32_bf16 v[36:39], v[112:115], v[88:91], v[36:39]
    v_mfma_f32_16x16x32_bf16 v[40:43], v[116:119], v[88:91], v[40:43]
    s_cmp_lt_u32 s42, s47
    s_cbranch_scc0 M3_r32
    v_mfma_f32_16x16x16_bf16 v[28:31], v[120:121], v[92:93], v[28:31]
    v_mfma_f32_16x16x16_bf16 v[32:35], v[122:123], v[92:93], v[32:35]
    v_mfma_f32_16x16x16_bf16 v[36:39], v[124:125], v[92:93], v[36:39]
    v_mfma_f32_16x16x16_bf16 v[40:43], v[126:127], v[92:93], v[40:43]
M3_r32:
    s_cmp_lg_u32 s42, 0
    s_cbranch_scc1 M3_loop
    s_branch L_loop_done
M3_rlast:
    s_cmp_lg_u32 s67, 0
    s_cbranch_scc1 M3_rnodma
    v_lshrrev_b32 v16, 2, v1
    v_lshlrev_b32 v16, 7, v16
    v_and_b32 v17, 3, v1
    v_lshl_add_u32 v16, v17, 5, v16
    v_lshlrev_b32 v17, 1, v1
    v_and_b32 v17, 16, v17
    v_or_b32 v16, v16, v17
    v_xor_b32 v17, 16, v16
    ds_read_b64_tr_b16 v[48:49], v16 offset:9472
    ds_read_b64_tr_b16 v[50:51], v16 offset:11520
    ds_read_b64_tr_b16 v[52:53], v16 offset:13568
    ds_read_b64_tr_b16 v[54:55], v16 offset:15616
    ds_read_b64_tr_b16 v[56:57], v16 offset:9480
    ds_read_b64_tr_b16 v[58:59], v16 offset:11528
    ds_read_b64_tr_b16 v[60:61], v16 offset:13576
    ds_read_b64_tr_b16 v[62:63], v16 offset:15624
    ds_read_b64_tr_b16 v[64:65], v17 offset:9472
    ds_read_b64_tr_b16 v[66:67], v17 offset:11520
    ds_read_b64_tr_b16 v[68:69], v17 offset:13568
    ds_read_b64_tr_b16 v[70:71], v17 offset:15616
    ds_read_b64_tr_b16 v[72:73], v17 offset:9480
    ds_read_b64_tr_b16 v[74:75], v17 offset:11528
    ds_read_b64_tr_b16 v[76:77], v17 offset:13576
    ds_read_b64_tr_b16 v[78:79], v17 offset:15624
    s_branch M3_rnodma
L_m4:
    s_cmp_eq_u32 s42, 5
    s_cbranch_scc1 M4_spec
    v_add_u32 v4, s3, v25
    ds_read_u16 v16, v4 offset:0
    ds_read_u16 v17, v4 offset:16
    ds_read_u16 v18, v4 offset:4096
    ds_read_u16 v19, v4 offset:4112
    ds_read_u16 v20, v4 offset:8192
    ds_read_u16 v21, v4 offset:8208
    ds_read_u16 v22, v4 offset:12288
    ds_read_u16 v23, v4 offset:12304
M4_spec:
    s_min_u32 s44, s45, s46
    s_min_u32 s44, s44, s47
    s_min_u32 s44, s44, s48
    s_sub_u32 s43, s42, 1
    s_waitcnt lgkmcnt(0)
    s_cmp_lt_u32 s43, s45
    s_cbranch_scc0 D5_0
    v_lshl_add_u32 v16, v16, 7, v2
    s_add_u32 m0, s37, 0
    v_lshl_add_u32 v17, v17, 7, v3
    buffer_load_dwordx4 v16, s[16:19], 0 offen lds
    s_add_u32 m0, s37, 1024
    s_nop 0
    buffer_load_dwordx4 v17, s[16:19], 0 offen lds
D5_0:
    s_cmp_lt_u32 s43, s46
    s_cbranch_scc0 D5_1
    v_lshl_add_u32 v18, v18, 7, v2
    s_add_u32 m0, s37, 2048
    v_lshl_add_u32 v19, v19, 7, v3
    buffer_load_dwordx4 v18, s[16:19], 0 offen lds
    s_add_u32 m0, s37, 3072
    s_nop 0
    buffer_load_dwordx4 v19, s[16:19], 0 offen lds
D5_1:
    s_cmp_lt_u32 s43, s47
    s_cbranch_scc0 D5_2
    v_lshl_add_u32 v20, v20, 7, v2
    s_add_u32 m0, s37, 4096
    v_lshl_add_u32 v21, v21, 7, v3
    buffer_load_dwordx4 v20, s[16:19], 0 offen lds
    s_add_u32 m0, s37, 5120
    s_nop 0
    buffer_load_dwordx4 v21, s[16:19], 0 offen lds
D5_2:
    s_cmp_lt_u32 s43, s48
    s_cbranch_scc0 D5_3
    v_lshl_add_u32 v22, v22, 7, v2
    s_add_u32 m0, s37, 6144
    v_lshl_add_u32 v23, v23, 7, v3
    buffer_load_dwordx4 v22, s[16:19], 0 offen lds
    s_add_u32 m0, s37, 7168
    s_nop 0
    buffer_load_dwordx4 v23, s[16:19], 0 offen lds
D5_3:
    v_mov_b32 v104, 0
    v_mov_b32 v105, 0
    v_mov_b32 v106, 0
    v_mov_b32 v107, 0
    v_mov_b32 v108, 0
    v_mov_b32 v109, 0
    v_mov_b32 v110, 0
    v_mov_b32 v111, 0
    v_mov_b32 v112, 0
    v_mov_b32 v113, 0
    v_mov_b32 v114, 0
    v_mov_b32 v115, 0
    v_mov_b32 v116, 0
    v_mov_b32 v117, 0
    v_mov_b32 v118, 0
    v_mov_b32 v119, 0
M4_loop:
    s_setprio 3
    s_cmp_gt_u32 s42, 3
    s_cbranch_scc1 M4_pd
    s_setprio 2
    s_cmp_gt_u32 s42, 2
    s_cbranch_scc1 M4_pd
    s_setprio 1
    s_cmp_gt_u32 s42, 1
    s_cbranch_scc1 M4_pd
    s_setprio 0
M4_pd:
    v_subrev_u32 v4, 32, v4
    s_sub_u32 s42, s42, 1
    s_sub_u32 s43, s42, 1
    ds_read_u16 v16, v4 offset:0
    ds_read_u16 v17, v4 offset:16
    ds_read_u16 v18, v4 offset:4096
    ds_read_u16 v19, v4 offset:4112
    ds_read_u16 v20, v4 offset:8192
    ds_read_u16 v21, v4 offset:8208
    ds_read_u16 v22, v4 offset:12288
    ds_read_u16 v23, v4 offset:12304
    s_cmp_ge_u32 s42, s44
    s_cbranch_scc1 M4_ramp
    s_waitcnt vmcnt(0)
    ds_read_b128 v[80:83], v5 offset:0
    ds_read_b128 v[84:87], v6 offset:0
    ds_read_b128 v[88:91], v5 offset:2048
    ds_read_b128 v[92:95], v6 offset:2048
    ds_read_b128 v[96:99], v5 offset:4096
    ds_read_b128 v[100:103], v6 offset:4096
    ds_read_b64_tr_b16 v[104:105], v7 offset:0
    ds_read_b64_tr_b16 v[108:109], v8 offset:0
    ds_read_b64_tr_b16 v[112:113], v9 offset:0
    ds_read_b64_tr_b16 v[116:117], v10 offset:0
    ds_read_b64_tr_b16 v[106:107], v7 offset:2048
    ds_read_b64_tr_b16 v[110:111], v8 offset:2048
    s_waitcnt lgkmcnt(10)
    v_mfma_f32_16x16x32_bf16 v[44:47], v[80:83], v[48:51], 0
    v_mfma_f32_16x16x32_bf16 v[44:47], v[84:87], v[52:55], v[44:47]
    ds_read_b64_tr_b16 v[114:115], v9 offset:2048
    ds_read_b64_tr_b16 v[118:119], v10 offset:2048
    ds_read_b64_tr_b16 v[120:121], v7 offset:4096
    ds_read_b64_tr_b16 v[122:123], v8 offset:4096
    ds_read_b64_tr_b16 v[124:125], v9 offset:4096
    ds_read_b64_tr_b16 v[126:127], v10 offset:4096
    ds_read_b128 v[80:83], v5 offset:6144
    ds_read_b128 v[84:87], v6 offset:6144
    s_waitcnt lgkmcnt(14)
    v_mfma_f32_16x16x32_bf16 v[44:47], v[88:91], v[56:59], v[44:47]
    v_mfma_f32_16x16x32_bf16 v[44:47], v[92:95], v[60:63], v[44:47]
    v_mfma_f32_16x16x32_bf16 v[44:47], v[96:99], v[64:67], v[44:47]
    v_mfma_f32_16x16x32_bf16 v[44:47], v[100:103], v[68:71], v[44:47]
    s_waitcnt lgkmcnt(0)
    v_mfma_f32_16x16x32_bf16 v[44:47], v[80:83], v[72:75], v[44:47]
    v_mfma_f32_16x16x32_bf16 v[44:47], v[84:87], v[76:79], v[44:47]
    ds_read_b64_tr_b16 v[80:81], v7 offset:6144
    ds_read_b64_tr_b16 v[82:83], v8 offset:6144
    ds_read_b64_tr_b16 v[84:85], v9 offset:6144
    ds_read_b64_tr_b16 v[86:87], v10 offset:6144
    s_waitcnt lgkmcnt(0)
    s_cmp_eq_u32 s42, 0
    s_cbranch_scc1 M4_last
    v_lshl_add_u32 v16, v16, 7, v2
    s_add_u32 m0, s37, 0
    v_lshl_add_u32 v17, v17, 7, v3
    buffer_load_dwordx4 v16, s[16:19], 0 offen lds
    s_add_u32 m0, s37, 1024
    s_nop 0
    buffer_load_dwordx4 v17, s[16:19], 0 offen lds
    v_lshl_add_u32 v18, v18, 7, v2
    s_add_u32 m0, s37, 2048
    v_lshl_add_u32 v19, v19, 7, v3
    buffer_load_dwordx4 v18, s[16:19], 0 offen lds
    s_add_u32 m0, s37, 3072
    s_nop 0
    buffer_load_dwordx4 v19, s[16:19], 0 offen lds
    v_lshl_add_u32 v20, v20, 7, v2
    s_add_u32 m0, s37, 4096
    v_lshl_add_u32 v21, v21, 7, v3
    buffer_load_dwordx4 v20, s[16:19], 0 offen lds
    s_add_u32 m0, s37, 5120
    s_nop 0
    buffer_load_dwordx4 v21, s[16:19], 0 offen lds
    v_lshl_add_u32 v22, v22, 7, v2
    s_add_u32 m0, s37, 6144
    v_lshl_add_u32 v23, v23, 7, v3
    buffer_load_dwordx4 v22, s[16:19], 0 offen lds
    s_add_u32 m0, s37, 7168
    s_nop 0
    buffer_load_dwordx4 v23, s[16:19], 0 offen lds
M4_nodma:
    v_mul_f32 v25, v44, v15
    v_mul_f32_dpp v25, v45, v15 row_shr:4 row_mask:0xf bank_mask:0x2
    v_mul_f32_dpp v25, v46, v15 row_shr:8 row_mask:0xf bank_mask:0x4
    v_mul_f32_dpp v25, v47, v15 row_shr:12 row_mask:0xf bank_mask:0x8
    v_exp_f32 v25, v25
    s_nop 0
    v_add_f32 v25, 1.0, v25
    v_rcp_f32 v25, v25
    s_nop 1
    v_mov_b32_dpp v26, v25 row_shl:4 row_mask:0xf bank_mask:0xf bound_ctrl:0
    v_cvt_pk_bf16_f32 v26, v25, v26
    v_and_b32 v88, v26, v11
    v_and_b32 v90, v26, v12
    v_and_b32 v92, v26, v13
    v_and_b32 v94, v26, v14
    v_and_b32_dpp v89, v26, v11 row_shl:8 row_mask:0xf bank_mask:0xf bound_ctrl:0
    v_and_b32_dpp v91, v26, v12 row_shl:8 row_mask:0xf bank_mask:0xf bound_ctrl:0
    v_and_b32_dpp v93, v26, v13 row_shl:8 row_mask:0xf bank_mask:0xf bound_ctrl:0
    v_and_b32_dpp v95, v26, v14 row_shl:8 row_mask:0xf bank_mask:0xf bound_ctrl:0
    s_nop 1
    v_mfma_f32_16x16x32_bf16 v[28:31], v[104:107], v[88:91], v[28:31]
    v_mfma_f32_16x16x32_bf16 v[32:35], v[108:111], v[88:91], v[32:35]
    v_mfma_f32_16x16x32_bf16 v[36:39], v[112:115], v[88:91], v[36:39]
    v_mfma_f32_16x16x32_bf16 v[40:43], v[116:119], v[88:91], v[40:43]
    v_mfma_f32_16x16x16_bf16 v[28:31], v[120:121], v[92:93], v[28:31]
    v_mfma_f32_16x16x16_bf16 v[32:35], v[122:123], v[92:93], v[32:35]
    v_mfma_f32_16x16x16_bf16 v[36:39], v[124:125], v[92:93], v[36:39]
    v_mfma_f32_16x16x16_bf16 v[40:43], v[126:127], v[92:93], v[40:43]
    v_mfma_f32_16x16x16_bf16 v[28:31], v[80:81], v[94:95], v[28:31]
    v_mfma_f32_16x16x16_bf16 v[32:35], v[82:83], v[94:95], v[32:35]
    v_mfma_f32_16x16x16_bf16 v[36:39], v[84:85], v[94:95], v[36:39]
    v_mfma_f32_16x16x16_bf16 v[40:43], v[86:87], v[94:95], v[40:43]
    s_cmp_lg_u32 s42, 0
    s_cbranch_scc1 M4_loop
    s_branch L_loop_done
M4_last:
    s_nop 4
    s_cmp_lg_u32 s67, 0
    s_cbranch_scc1 M4_nodma
    v_lshrrev_b32 v16, 2, v1
    v_lshlrev_b32 v16, 7, v16
    v_and_b32 v17, 3, v1
    v_lshl_add_u32 v16, v17, 5, v16
    v_lshlrev_b32 v17, 1, v1
    v_and_b32 v17, 16, v17
    v_or_b32 v16, v16, v17
    v_xor_b32 v17, 16, v16
    ds_read_b64_tr_b16 v[48:49], v16 offset:9472
    ds_read_b64_tr_b16 v[50:51], v16 offset:11520
    ds_read_b64_tr_b16 v[52:53], v16 offset:13568
    ds_read_b64_tr_b16 v[54:55], v16 offset:15616
    ds_read_b64_tr_b16 v[56:57], v16 offset:9480
    ds_read_b64_tr_b16 v[58:59], v16 offset:11528
    ds_read_b64_tr_b16 v[60:61], v16 offset:13576
    ds_read_b64_tr_b16 v[62:63], v16 offset:15624
    ds_read_b64_tr_b16 v[64:65], v17 offset:9472
    ds_read_b64_tr_b16 v[66:67], v17 offset:11520
    ds_read_b64_tr_b16 v[68:69], v17 offset:13568
    ds_read_b64_tr_b16 v[70:71], v17 offset:15616
    ds_read_b64_tr_b16 v[72:73], v17 offset:9480
    ds_read_b64_tr_b16 v[74:75], v17 offset:11528
    ds_read_b64_tr_b16 v[76:77], v17 offset:13576
    ds_read_b64_tr_b16 v[78:79], v17 offset:15624
    s_branch M4_nodma
M4_ramp:
    v_mov_b32 v44, 0
    v_mov_b32 v45, 0
    v_mov_b32 v46, 0
    v_mov_b32 v47, 0
    s_waitcnt vmcnt(0)
    s_cmp_lt_u32 s42, s45
    s_cbranch_scc0 M4_r10
    ds_read_b128 v[80:83], v5 offset:0
    ds_read_b128 v[84:87], v6 offset:0
    ds_read_b64_tr_b16 v[104:105], v7 offset:0
    ds_read_b64_tr_b16 v[108:109], v8 offset:0
    ds_read_b64_tr_b16 v[112:113], v9 offset:0
    ds_read_b64_tr_b16 v[116:117], v10 offset:0
M4_r10:
    s_cmp_lt_u32 s42, s46
    s_cbranch_scc0 M4_r11
    ds_read_b128 v[88:91], v5 offset:2048
    ds_read_b128 v[92:95], v6 offset:2048
    ds_read_b64_tr_b16 v[106:107], v7 offset:2048
    ds_read_b64_tr_b16 v[110:111], v8 offset:2048
    ds_read_b64_tr_b16 v[114:115], v9 offset:2048
    ds_read_b64_tr_b16 v[118:119], v10 offset:2048
M4_r11:
    s_cmp_lt_u32 s42, s47
    s_cbranch_scc0 M4_r12
    ds_read_b128 v[96:99], v5 offset:4096
    ds_read_b128 v[100:103], v6 offset:4096
    ds_read_b64_tr_b16 v[120:121], v7 offset:4096
    ds_read_b64_tr_b16 v[122:123], v8 offset:4096
    ds_read_b64_tr_b16 v[124:125], v9 offset:4096
    ds_read_b64_tr_b16 v[126:127], v10 offset:4096
M4_r12:
    s_waitcnt lgkmcnt(0)
    s_cmp_lt_u32 s42, s45
    s_cbranch_scc0 M4_r20
    v_mfma_f32_16x16x32_bf16 v[44:47], v[80:83], v[48:51], v[44:47]
    v_mfma_f32_16x16x32_bf16 v[44:47], v[84:87], v[52:55], v[44:47]
M4_r20:
    s_cmp_lt_u32 s42, s46
    s_cbranch_scc0 M4_r21
    v_mfma_f32_16x16x32_bf16 v[44:47], v[88:91], v[56:59], v[44:47]
    v_mfma_f32_16x16x32_bf16 v[44:47], v[92:95], v[60:63], v[44:47]
M4_r21:
    s_cmp_lt_u32 s42, s47
    s_cbranch_scc0 M4_r22
    v_mfma_f32_16x16x32_bf16 v[44:47], v[96:99], v[64:67], v[44:47]
    v_mfma_f32_16x16x32_bf16 v[44:47], v[100:103], v[68:71], v[44:47]
M4_r22:
    s_cmp_lt_u32 s42, s48
    s_cbranch_scc0 M4_r23
    ds_read_b128 v[80:83], v5 offset:6144
    ds_read_b128 v[84:87], v6 offset:6144
    s_waitcnt lgkmcnt(0)
    v_mfma_f32_16x16x32_bf16 v[44:47], v[80:83], v[72:75], v[44:47]
    v_mfma_f32_16x16x32_bf16 v[44:47], v[84:87], v[76:79], v[44:47]
    ds_read_b64_tr_b16 v[80:81], v7 offset:6144
    ds_read_b64_tr_b16 v[82:83], v8 offset:6144
    ds_read_b64_tr_b16 v[84:85], v9 offset:6144
    ds_read_b64_tr_b16 v[86:87], v10 offset:6144
    s_waitcnt lgkmcnt(0)
M4_r23:
    s_cmp_eq_u32 s42, 0
    s_cbranch_scc1 M4_rlast
    s_cmp_lt_u32 s43, s45
    s_cbranch_scc0 D7_0
    v_lshl_add_u32 v16, v16, 7, v2
    s_add_u32 m0, s37, 0
    v_lshl_add_u32 v17, v17, 7, v3
    buffer_load_dwordx4 v16, s[16:19], 0 offen lds
    s_add_u32 m0, s37, 1024
    s_nop 0
    buffer_load_dwordx4 v17, s[16:19], 0 offen lds
D7_0:
    s_cmp_lt_u32 s43, s46
    s_cbranch_scc0 D7_1
    v_lshl_add_u32 v18, v18, 7, v2
    s_add_u32 m0, s37, 2048
    v_lshl_add_u32 v19, v19, 7, v3
    buffer_load_dwordx4 v18, s[16:19], 0 offen lds
    s_add_u32 m0, s37, 3072
    s_nop 0
    buffer_load_dwordx4 v19, s[16:19], 0 offen lds
D7_1:
    s_cmp_lt_u32 s43, s47
    s_cbranch_scc0 D7_2
    v_lshl_add_u32 v20, v20, 7, v2
    s_add_u32 m0, s37, 4096
    v_lshl_add_u32 v21, v21, 7, v3
    buffer_load_dwordx4 v20, s[16:19], 0 offen lds
    s_add_u32 m0, s37, 5120
    s_nop 0
    buffer_load_dwordx4 v21, s[16:19], 0 offen lds
D7_2:
    s_cmp_lt_u32 s43, s48
    s_cbranch_scc0 D7_3
    v_lshl_add_u32 v22, v22, 7, v2
    s_add_u32 m0, s37, 6144
    v_lshl_add_u32 v23, v23, 7, v3
    buffer_load_dwordx4 v22, s[16:19], 0 offen lds
    s_add_u32 m0, s37, 7168
    s_nop 0
    buffer_load_dwordx4 v23, s[16:19], 0 offen lds
D7_3:
M4_rnodma:
    s_nop 7
    v_mul_f32 v25, v44, v15
    v_mul_f32_dpp v25, v45, v15 row_shr:4 row_mask:0xf bank_mask:0x2
    v_mul_f32_dpp v25, v46, v15 row_shr:8 row_mask:0xf bank_mask:0x4
    v_mul_f32_dpp v25, v47, v15 row_shr:12 row_mask:0xf bank_mask:0x8
    v_exp_f32 v25, v25
    s_nop 0
    v_add_f32 v25, 1.0, v25
    v_rcp_f32 v25, v25
    s_nop 1
    v_mov_b32_dpp v26, v25 row_shl:4 row_mask:0xf bank_mask:0xf bound_ctrl:0
    v_cvt_pk_bf16_f32 v26, v25, v26
    v_and_b32 v88, v26, v11
    v_and_b32 v90, v26, v12
    v_and_b32 v92, v26, v13
    v_and_b32 v94, v26, v14
    v_and_b32_dpp v89, v26, v11 row_shl:8 row_mask:0xf bank_mask:0xf bound_ctrl:0
    v_and_b32_dpp v91, v26, v12 row_shl:8 row_mask:0xf bank_mask:0xf bound_ctrl:0
    v_and_b32_dpp v93, v26, v13 row_shl:8 row_mask:0xf bank_mask:0xf bound_ctrl:0
    v_and_b32_dpp v95, v26, v14 row_shl:8 row_mask:0xf bank_mask:0xf bound_ctrl:0
    s_nop 1
    v_mfma_f32_16x16x32_bf16 v[28:31], v[104:107], v[88:91], v[28:31]
    v_mfma_f32_16x16x32_bf16 v[32:35], v[108:111], v[88:91], v[32:35]
    v_mfma_f32_16x16x32_bf16 v[36:39], v[112:115], v[88:91], v[36:39]
    v_mfma_f32_16x16x32_bf16 v[40:43], v[116:119], v[88:91], v[40:43]
    s_cmp_lt_u32 s42, s47
    s_cbranch_scc0 M4_r32
    v_mfma_f32_16x16x16_bf16 v[28:31], v[120:121], v[92:93], v[28:31]
    v_mfma_f32_16x16x16_bf16 v[32:35], v[122:123], v[92:93], v[32:35]
    v_mfma_f32_16x16x16_bf16 v[36:39], v[124:125], v[92:93], v[36:39]
    v_mfma_f32_16x16x16_bf16 v[40:43], v[126:127], v[92:93], v[40:43]
M4_r32:
    s_cmp_lt_u32 s42, s48
    s_cbranch_scc0 M4_r33
    v_mfma_f32_16x16x16_bf16 v[28:31], v[80:81], v[94:95], v[28:31]
    v_mfma_f32_16x16x16_bf16 v[32:35], v[82:83], v[94:95], v[32:35]
    v_mfma_f32_16x16x16_bf16 v[36:39], v[84:85], v[94:95], v[36:39]
    v_mfma_f32_16x16x16_bf16 v[40:43], v[86:87], v[94:95], v[40:43]
M4_r33:
    s_cmp_lg_u32 s42, 0
    s_cbranch_scc1 M4_loop
    s_branch L_loop_done
M4_rlast:
    s_cmp_lg_u32 s67, 0
    s_cbranch_scc1 M4_rnodma
    v_lshrrev_b32 v16, 2, v1
    v_lshlrev_b32 v16, 7, v16
    v_and_b32 v17, 3, v1
    v_lshl_add_u32 v16, v17, 5, v16
    v_lshlrev_b32 v17, 1, v1
    v_and_b32 v17, 16, v17
    v_or_b32 v16, v16, v17
    v_xor_b32 v17, 16, v16
    ds_read_b64_tr_b16 v[48:49], v16 offset:9472
    ds_read_b64_tr_b16 v[50:51], v16 offset:11520
    ds_read_b64_tr_b16 v[52:53], v16 offset:13568
    ds_read_b64_tr_b16 v[54:55], v16 offset:15616
    ds_read_b64_tr_b16 v[56:57], v16 offset:9480
    ds_read_b64_tr_b16 v[58:59], v16 offset:11528
    ds_read_b64_tr_b16 v[60:61], v16 offset:13576
    ds_read_b64_tr_b16 v[62:63], v16 offset:15624
    ds_read_b64_tr_b16 v[64:65], v17 offset:9472
    ds_read_b64_tr_b16 v[66:67], v17 offset:11520
    ds_read_b64_tr_b16 v[68:69], v17 offset:13568
    ds_read_b64_tr_b16 v[70:71], v17 offset:15616
    ds_read_b64_tr_b16 v[72:73], v17 offset:9480
    ds_read_b64_tr_b16 v[74:75], v17 offset:11528
    ds_read_b64_tr_b16 v[76:77], v17 offset:13576
    ds_read_b64_tr_b16 v[78:79], v17 offset:15624
    s_branch M4_rnodma
L_loop_done:
    s_cmp_lg_u32 s67, 0
    s_cbranch_scc1 L_slow_next
L_epi:
    s_cmp_lg_u32 s36, 0
    s_cbranch_scc1 L_nochk
    v_mov_b32 v25, 0
    buffer_load_dword v26, v25, s[96:99], 0 offen sc1
L_nochk:
    v_and_b32 v122, 15, v1
    v_lshlrev_b32 v122, 19, v122
    v_lshrrev_b32 v123, 4, v1
    v_lshl_add_u32 v122, v123, 5, v122
    s_lshl_b32 s3, s36, 8
    s_add_u32 s3, s3, s2
    s_lshl_b32 s3, s3, 7
    v_add_u32 v122, s3, v122
    v_cvt_pk_bf16_f32 v80, v28, v29
    v_cvt_pk_bf16_f32 v81, v30, v31
    v_cvt_pk_bf16_f32 v82, v32, v33
    v_cvt_pk_bf16_f32 v83, v34, v35
    v_cvt_pk_bf16_f32 v84, v36, v37
    v_cvt_pk_bf16_f32 v85, v38, v39
    v_cvt_pk_bf16_f32 v86, v40, v41
    v_cvt_pk_bf16_f32 v87, v42, v43
    s_mov_b32 s64, 0x000f000f
    s_mov_b32 s65, 0x000f000f
    s_waitcnt lgkmcnt(12)
    v_mfma_f32_16x16x32_bf16 v[104:107], v[48:51], v[80:83], 0
    v_mfma_f32_16x16x32_bf16 v[104:107], v[52:55], v[84:87], v[104:107]
    s_waitcnt lgkmcnt(8)
    v_mfma_f32_16x16x32_bf16 v[108:111], v[56:59], v[80:83], 0
    v_mfma_f32_16x16x32_bf16 v[108:111], v[60:63], v[84:87], v[108:111]
    s_waitcnt lgkmcnt(4)
    v_mfma_f32_16x16x32_bf16 v[112:115], v[64:67], v[80:83], 0
    v_mfma_f32_16x16x32_bf16 v[112:115], v[68:71], v[84:87], v[112:115]
    s_waitcnt lgkmcnt(0)
    v_mfma_f32_16x16x32_bf16 v[116:119], v[72:75], v[80:83], 0
    v_mfma_f32_16x16x32_bf16 v[116:119], v[76:79], v[84:87], v[116:119]
    s_mov_b64 exec, s[64:65]
    s_nop 2
    v_cvt_pk_bf16_f32 v88, v104, v105
    v_cvt_pk_bf16_f32 v89, v106, v107
    v_cvt_pk_bf16_f32 v90, v108, v109
    v_cvt_pk_bf16_f32 v91, v110, v111
    buffer_store_dwordx4 v[88:91], v122, s[32:35], 0 offen nt
    v_cvt_pk_bf16_f32 v92, v112, v113
    v_cvt_pk_bf16_f32 v93, v114, v115
    s_nop 3
    v_cvt_pk_bf16_f32 v94, v116, v117
    v_cvt_pk_bf16_f32 v95, v118, v119
    buffer_store_dwordx4 v[92:95], v122, s[32:35], 0 offen offset:16 nt
    s_mov_b64 exec, -1
    s_or_b32 s3, s58, s36
    s_cbranch_scc1 L_noep
    s_cmp_eq_u32 s49, 0
    s_cbranch_scc1 L_pub
    s_waitcnt vmcnt(2)
    v_readfirstlane_b32 s3, v26
    s_cmp_eq_u32 s3, 0
    s_cbranch_scc1 L_noep
L_pub:
    v_mov_b32 v104, s50
    v_mov_b32 v105, s51
    v_mov_b32 v106, s52
    v_mov_b32 v107, s53
    v_mov_b32 v108, 0
    s_add_u32 s68, s14, 13631488
    s_addc_u32 s69, s15, 0
    s_mov_b32 s70, 16
    s_mov_b32 s71, 0x20000
    s_mov_b64 exec, 1
    buffer_store_dwordx4 v[104:107], v108, s[68:71], 0 offen sc1
    s_mov_b64 exec, -1
L_noep:
L_end:
    s_endpgm
L_r0:
    s_cmp_lg_u32 s67, 0
    s_cbranch_scc1 L_slow_next
L_epi_ld:
    v_lshrrev_b32 v16, 2, v1
    v_lshlrev_b32 v16, 7, v16
    v_and_b32 v17, 3, v1
    v_lshl_add_u32 v16, v17, 5, v16
    v_lshlrev_b32 v17, 1, v1
    v_and_b32 v17, 16, v17
    v_or_b32 v16, v16, v17
    v_xor_b32 v17, 16, v16
    ds_read_b64_tr_b16 v[48:49], v16 offset:9472
    ds_read_b64_tr_b16 v[50:51], v16 offset:11520
    ds_read_b64_tr_b16 v[52:53], v16 offset:13568
    ds_read_b64_tr_b16 v[54:55], v16 offset:15616
    ds_read_b64_tr_b16 v[56:57], v16 offset:9480
    ds_read_b64_tr_b16 v[58:59], v16 offset:11528
    ds_read_b64_tr_b16 v[60:61], v16 offset:13576
    ds_read_b64_tr_b16 v[62:63], v16 offset:15624
    ds_read_b64_tr_b16 v[64:65], v17 offset:9472
    ds_read_b64_tr_b16 v[66:67], v17 offset:11520
    ds_read_b64_tr_b16 v[68:69], v17 offset:13568
    ds_read_b64_tr_b16 v[70:71], v17 offset:15616
    ds_read_b64_tr_b16 v[72:73], v17 offset:9480
    ds_read_b64_tr_b16 v[74:75], v17 offset:11528
    ds_read_b64_tr_b16 v[76:77], v17 offset:13576
    ds_read_b64_tr_b16 v[78:79], v17 offset:15624
    s_branch L_epi
L_rescan_done:
    v_lshrrev_b32 v25, 3, v1
    v_lshl_add_u32 v25, v25, 1, s41
    v_lshlrev_b32 v44, 2, v1
    v_lshlrev_b32 v45, 8, v1
    v_subrev_u32 v45, 4294831903, v45
    v_add_u32 v4, 160, v25
    s_add_u32 s84, s36, 16
    s_add_u32 s85, s36, 32
    s_add_u32 s86, s36, 48
    s_min_u32 s86, s86, 49
    s_movk_i32 s87, 287
    s_branch L_b6
L_third:
    ds_read_b128 v[80:83], v125 offset:35200
    v_add_u32 v115, 64, v122
    v_cmp_lt_u32 s[64:65], v115, v112
    s_waitcnt lgkmcnt(0)
    v_xor_b32 v80, v113, v80
    v_cndmask_b32 v114, 4.0, v44, s[64:65]
    v_xor_b32 v81, s51, v81
    v_xor_b32 v82, s52, v82
    v_xor_b32 v83, s53, v83
    buffer_store_dwordx4 v[80:83], v114, s[28:31], s55 offen sc1
    s_mov_b32 s59, 1
    s_branch L_third_done
L_more:
    s_mov_b64 s[74:75], s[62:63]
    s_waitcnt lgkmcnt(0)
    s_mov_b64 exec, s[62:63]
    buffer_load_dwordx4 v[108:111], v121, s[68:71], 0 offen sc1
    s_branch L_sec
L_hretry:
    s_sub_u32 s66, s66, 1
    s_cbranch_scc1 L_hto
    s_sleep 2
    s_mov_b64 exec, s[60:61]
    buffer_load_dwordx4 v[104:107], v120, s[68:71], 0 offen sc1
    s_waitcnt vmcnt(0)
    s_branch L_hv
L_hto:
    s_mov_b32 s66, 0
    s_lshr_b64 s[64:65], s[60:61], 1
    s_or_b64 s[60:61], s[60:61], s[64:65]
    s_lshr_b64 s[64:65], s[60:61], 2
    s_or_b64 s[60:61], s[60:61], s[64:65]
    s_and_b32 s60, s60, 0x11111111
    s_and_b32 s61, s61, 0x11111111
    s_mul_i32 s56, s60, 15
    s_mul_i32 s57, s61, 15
    s_mov_b64 exec, -1
    v_mov_b32 v113, 212
    v_mov_b32 v114, 0
    s_mov_b64 exec, 1
    ds_add_u32 v113, v124 offset:0
    buffer_store_dword v113, v114, s[96:99], 0 offen sc1
    s_branch L_hok
L_sretry:
    s_sub_u32 s66, s66, 1
    s_cbranch_scc1 L_force_slow
    s_sleep 2
    s_mov_b64 exec, s[62:63]
    buffer_load_dwordx4 v[108:111], v121, s[68:71], 0 offen sc1
    s_waitcnt vmcnt(0)
    s_branch L_sv
L_force_slow:
    s_mov_b64 exec, -1
    s_waitcnt vmcnt(0)
    v_mov_b32 v113, 0x10000
    v_mov_b32 v104, 220
    s_mov_b64 exec, 1
    ds_add_u32 v104, v113 offset:0
    s_mov_b64 exec, -1
    s_branch L_rescan_done
L_rescan:
    s_lshl_b32 s72, s36, 4
L_rs_next:
    s_cmp_eq_u64 s[56:57], 0
    s_cbranch_scc1 L_rescan_done
    s_ff1_i32_b64 s73, s[56:57]
    s_lshl_b64 s[64:65], 15, s73
    s_andn2_b64 s[56:57], s[56:57], s[64:65]
    s_lshr_b32 s73, s73, 2
    s_add_u32 s73, s73, s72
    s_mul_i32 s73, s73, 12512
    s_mov_b32 s74, 0
L_rs_loop:
    v_add_u32 v25, s74, v1
    v_lshl_add_u32 v26, v25, 4, s73
    v_cmp_gt_u32 vcc, 782, v25
    s_mov_b64 s[62:63], vcc
    v_cmp_gt_u32 vcc, 3200000, v26
    s_and_b64 s[62:63], s[62:63], vcc
    s_mov_b64 exec, s[62:63]
    buffer_load_dwordx4 v[104:107], v26, s[20:23], 0 offen
    buffer_load_dwordx4 v[108:111], v26, s[24:27], 0 offen
    v_mov_b32 v116, 2
    s_mov_b32 s3, 0x050c0100
    s_waitcnt vmcnt(0)
    v_and_b32 v112, 0xff, v104
    v_cmp_eq_u32 s[42:43], s2, v112
    v_perm_b32 v108, v104, v108, s3
    v_and_b32 v113, 0xff, v105
    v_cmp_eq_u32 s[44:45], s2, v113
    v_perm_b32 v109, v105, v109, s3
    v_and_b32 v114, 0xff, v106
    v_cmp_eq_u32 s[46:47], s2, v114
    v_perm_b32 v110, v106, v110, s3
    v_and_b32 v115, 0xff, v107
    v_cmp_eq_u32 s[64:65], s2, v115
    v_perm_b32 v111, v107, v111, s3
    s_mov_b64 exec, s[42:43]
    v_lshrrev_b32 v112, 22, v108
    ds_add_rtn_u32 v112, v112, v116 offset:0
    s_mov_b64 exec, s[44:45]
    v_lshrrev_b32 v113, 22, v109
    ds_add_rtn_u32 v113, v113, v116 offset:0
    s_mov_b64 exec, s[46:47]
    v_lshrrev_b32 v114, 22, v110
    ds_add_rtn_u32 v114, v114, v116 offset:0
    s_mov_b64 exec, s[64:65]
    v_lshrrev_b32 v115, 22, v111
    ds_add_rtn_u32 v115, v115, v116 offset:0
    s_mov_b64 exec, s[42:43]
    s_waitcnt lgkmcnt(3)
    ds_write_b16 v112, v108
    s_mov_b64 exec, s[44:45]
    s_waitcnt lgkmcnt(3)
    ds_write_b16 v113, v109
    s_mov_b64 exec, s[46:47]
    s_waitcnt lgkmcnt(3)
    ds_write_b16 v114, v110
    s_mov_b64 exec, s[64:65]
    s_waitcnt lgkmcnt(3)
    ds_write_b16 v115, v111
    s_mov_b64 exec, -1
    s_add_u32 s74, s74, 64
    s_cmp_lt_u32 s74, 782
    s_cbranch_scc1 L_rs_loop
    s_branch L_rs_next
L_slow:
    s_mov_b32 s67, 1
    s_mov_b32 s75, 0
    s_mov_b32 s13, 0
    s_waitcnt vmcnt(0)
L_slow_next:
    s_cmp_ge_u32 s75, 3200000
    s_cbranch_scc1 L_epi_ld
    s_barrier
    v_mov_b32 v80, -1
    v_mov_b32 v81, -1
    v_mov_b32 v82, -1
    v_mov_b32 v83, -1
    v_lshlrev_b32 v84, 4, v0
    v_add_u32 v84, 135424, v84
    v_cmp_gt_u32 vcc, 784, v0
    s_mov_b64 exec, vcc
    ds_write_b128 v84, v[80:83]
    s_mov_b64 exec, -1
    s_cmp_lg_u32 s36, 13
    s_cbranch_scc1 I8
    v_lshlrev_b32 v85, 2, v1
    v_lshlrev_b32 v86, 8, v1
    v_add_u32 v86, 135424, v86
    v_mov_b32 v84, s40
    v_cmp_le_u32 vcc, 56, v1
    s_nop 1
    v_cndmask_b32 v86, v86, v84, vcc
    ds_write_b32 v85, v86 offset:0
I8:
    s_waitcnt lgkmcnt(0)
    s_barrier
    v_lshl_add_u32 v26, v0, 4, s75
    v_cmp_gt_u32 vcc, 28, v0
    s_mov_b64 s[62:63], vcc
    v_cmp_gt_u32 vcc, 3200000, v26
    s_and_b64 s[62:63], s[62:63], vcc
    s_cbranch_scc0 L_slow_skip
    s_mov_b64 exec, s[62:63]
    buffer_load_dwordx4 v[104:107], v26, s[20:23], 0 offen
    buffer_load_dwordx4 v[108:111], v26, s[24:27], 0 offen
    v_mov_b32 v116, 2
    s_mov_b32 s3, 0x050c0100
    s_waitcnt vmcnt(0)
    v_and_b32 v112, 0xff, v104
    v_cmp_eq_u32 s[42:43], s2, v112
    v_perm_b32 v108, v104, v108, s3
    v_and_b32 v113, 0xff, v105
    v_cmp_eq_u32 s[44:45], s2, v113
    v_perm_b32 v109, v105, v109, s3
    v_and_b32 v114, 0xff, v106
    v_cmp_eq_u32 s[46:47], s2, v114
    v_perm_b32 v110, v106, v110, s3
    v_and_b32 v115, 0xff, v107
    v_cmp_eq_u32 s[64:65], s2, v115
    v_perm_b32 v111, v107, v111, s3
    s_mov_b64 exec, s[42:43]
    v_lshrrev_b32 v112, 22, v108
    ds_add_rtn_u32 v112, v112, v116 offset:0
    s_mov_b64 exec, s[44:45]
    v_lshrrev_b32 v113, 22, v109
    ds_add_rtn_u32 v113, v113, v116 offset:0
    s_mov_b64 exec, s[46:47]
    v_lshrrev_b32 v114, 22, v110
    ds_add_rtn_u32 v114, v114, v116 offset:0
    s_mov_b64 exec, s[64:65]
    v_lshrrev_b32 v115, 22, v111
    ds_add_rtn_u32 v115, v115, v116 offset:0
    s_mov_b64 exec, s[42:43]
    s_waitcnt lgkmcnt(3)
    ds_write_b16 v112, v108
    s_mov_b64 exec, s[44:45]
    s_waitcnt lgkmcnt(3)
    ds_write_b16 v113, v109
    s_mov_b64 exec, s[46:47]
    s_waitcnt lgkmcnt(3)
    ds_write_b16 v114, v110
    s_mov_b64 exec, s[64:65]
    s_waitcnt lgkmcnt(3)
    ds_write_b16 v115, v111
    s_mov_b64 exec, -1
L_slow_skip:
    s_add_u32 s75, s75, 448
    s_branch L_rescan_done
.section .rodata,"a"
.p2align 6
.amdhsa_kernel gather_scatter__kernel_systems_refs_featgraph__graph_kernel
  .amdhsa_next_free_vgpr 128
  .amdhsa_next_free_sgpr 102
  .amdhsa_accum_offset 128
  .amdhsa_group_segment_fixed_size 0
  .amdhsa_kernarg_size 64
  .amdhsa_user_sgpr_count 2
  .amdhsa_user_sgpr_kernarg_segment_ptr 1
  .amdhsa_system_sgpr_workgroup_id_x 1
.end_amdhsa_kernel
```
